```python
import torch

def _softmax(x, axis=-1):
    return torch.softmax(x, dim=axis)

def _gelu(x):
    return torch.nn.functional.gelu(x, approximate='tanh')

def _silu(x):
    return torch.nn.functional.silu(x)

def _sigmoid(x):
    return torch.sigmoid(x)

def _layernorm(x, axis=-1, eps=1e-05):
    m = x.mean(dim=axis, keepdim=True)
    v = x.var(dim=axis, keepdim=True, unbiased=False)
    return (x - m) / torch.sqrt(v + eps)

def _scatter_add(tgt, idx, src, axis=0):
    return tgt.clone().index_add_(axis, idx, src)

def _segment_sum(src, seg, n):
    out = torch.zeros((n,) + src.shape[1:], dtype=src.dtype)
    return out.index_add_(0, seg, src)

def _pad(x, pw):
    flat = tuple((v for pair in reversed(pw) for v in pair))
    return torch.nn.functional.pad(x, flat)
kernel_name = 'standalone__tree_speculative_verify_tree_attention_over_candidate_token_tree__decode'

def setup_inputs():

    _w = lambda a: (lambda t: t.to(torch.bfloat16) if t.is_floating_point() else t)(torch.as_tensor(a))
    B, Hq, Hkv, T, C, D = (8, 32, 4, 1, 4096, 128)
    tree_mask = torch.zeros((B, T, T), dtype=float)
    for b in range(B):
        parent = torch.zeros(T, dtype=torch.int64)
        for i in range(1, T):
            parent[i] = int(torch.randint(0, i, (1,)).item())
        for i in range(T):
            j = i
            tree_mask[b, i, j] = 1.0
            while j > 0:
                j = parent[j]
                tree_mask[b, i, j] = 1.0
    return {'q': _w((lambda *s: torch.randn(*s, dtype=torch.bfloat16) * 0.8)(B, Hq, T, D)), 'k_cache': _w((lambda *s: torch.randn(*s, dtype=torch.bfloat16) * 0.8)(B, Hkv, C, D)), 'v_cache': _w((lambda *s: torch.randn(*s, dtype=torch.bfloat16) * 0.05)(B, Hkv, C, D)), 'k_tree': _w((lambda *s: torch.randn(*s, dtype=torch.bfloat16) * 0.8)(B, Hkv, T, D)), 'v_tree': _w((lambda *s: torch.randn(*s, dtype=torch.bfloat16) * 0.05)(B, Hkv, T, D)), 'tree_mask': _w(tree_mask)}

def reference(q, k_cache, v_cache, k_tree, v_tree, tree_mask):
    B, Hq, T, D = q.shape
    Hkv, C = (k_cache.shape[1], k_cache.shape[2])
    rep = Hq // Hkv
    kc = (lambda x, n, axis: torch.repeat_interleave(x, n, dim=axis))(k_cache, rep, axis=1)
    vc = (lambda x, n, axis: torch.repeat_interleave(x, n, dim=axis))(v_cache, rep, axis=1)
    kt = (lambda x, n, axis: torch.repeat_interleave(x, n, dim=axis))(k_tree, rep, axis=1)
    vt = (lambda x, n, axis: torch.repeat_interleave(x, n, dim=axis))(v_tree, rep, axis=1)
    k = torch.concatenate([kc, kt], axis=2)
    v = torch.concatenate([vc, vt], axis=2)
    scale = D ** (-0.5)
    scores = torch.einsum('bhqd,bhkd->bhqk', q, k) * scale
    ctx_mask = torch.ones((B, 1, T, C), dtype=scores.dtype)
    tm = tree_mask[:, None, :, :].clone()
    full_mask = torch.concatenate([ctx_mask, tm], axis=-1)
    scores = scores + (1.0 - full_mask) * -1000000000.0
    p = _softmax(scores, axis=-1)
    return torch.einsum('bhqk,bhkd->bhqd', p, v)
```

```asm
; @launch grid=(256,1,1) block=(320,1,1) lds=148480
.amdgcn_target "amdgcn-amd-amdhsa--gfx950"
.text
.globl standalone__tree_speculative_verify_tree_attention_over_candidate_token_tree__decode_kernel
.p2align 8
.type standalone__tree_speculative_verify_tree_attention_over_candidate_token_tree__decode_kernel,@function
standalone__tree_speculative_verify_tree_attention_over_candidate_token_tree__decode_kernel:
    s_cmp_ge_u32 s2, 256
    s_cbranch_scc1 L_END
    s_and_b32 s4, s2, 7
    s_lshl_b32 s4, s4, 5
    s_bfe_u32 s5, s2, 0x20003
    s_lshl_b32 s5, s5, 3
    s_lshr_b32 s2, s2, 5
    s_or_b32 s2, s2, s4
    s_or_b32 s2, s2, s5
    s_load_dwordx2 s[8:9], s[0:1], 8
    s_load_dwordx2 s[12:13], s[0:1], 16
    s_load_dwordx2 s[16:17], s[0:1], 0
    s_load_dwordx2 s[20:21], s[0:1], 64
    v_lshrrev_b32 v5, 6, v0
    v_and_b32 v1, 63, v0
    v_readfirstlane_b32 s3, v5
    s_mov_b32 s10, 0x2000000
    s_mov_b32 s11, 0x20000
    s_mov_b32 s14, 0x2000000
    s_mov_b32 s15, 0x20000
    s_mov_b32 s18, 0x10000
    s_mov_b32 s19, 0x20000
    s_mov_b32 s22, 0x10000000
    s_mov_b32 s23, 0x20000
    s_lshr_b32 s58, s2, 3
    s_and_b32 s59, s2, 7
    s_cmp_eq_u32 s3, 4
    s_cbranch_scc1 L_CTRL
    v_and_b32 v8, 15, v1
    v_lshrrev_b32 v9, 4, v1
    v_lshlrev_b32 v10, 2, v9
    v_xor_b32 v10, v8, v10
    v_lshlrev_b32 v11, 8, v9
    v_lshl_or_b32 v2, v10, 4, v11
    v_xor_b32 v3, 16, v2
    v_xor_b32 v4, 32, v2
    v_xor_b32 v5, 48, v2
    s_lshl_b32 s55, s3, 15
    s_lshl_b32 s4, s2, 17
    s_add_u32 s4, s4, s55
    s_mov_b32 s44, s4
    s_add_u32 s45, s4, 4096
    s_add_u32 s46, s4, 8192
    s_add_u32 s47, s4, 12288
    s_add_u32 s48, s4, 16384
    s_add_u32 s49, s4, 20480
    s_add_u32 s50, s4, 24576
    s_add_u32 s51, s4, 28672
    v_lshlrev_b32 v6, 4, v1
    s_lshl_b32 s63, s58, 17
    s_add_u32 s63, s63, 0xC000
    s_waitcnt lgkmcnt(0)
    s_buffer_load_dword s64, s[20:23], s63
    s_add_u32 m0, s55, 0
    s_nop 0
    buffer_load_dwordx4 v2, s[8:11], s44 offen offset:0 lds
    buffer_load_dwordx4 v3, s[8:11], s44 offen offset:1024 lds
    buffer_load_dwordx4 v4, s[8:11], s44 offen offset:2048 lds
    buffer_load_dwordx4 v5, s[8:11], s44 offen offset:3072 lds
    s_add_u32 m0, s55, 4096
    s_nop 0
    buffer_load_dwordx4 v2, s[8:11], s45 offen offset:0 lds
    buffer_load_dwordx4 v3, s[8:11], s45 offen offset:1024 lds
    buffer_load_dwordx4 v4, s[8:11], s45 offen offset:2048 lds
    buffer_load_dwordx4 v5, s[8:11], s45 offen offset:3072 lds
    s_barrier
    v_and_b32 v56, 7, v1
    v_lshrrev_b32 v57, 4, v1
    v_lshlrev_b32 v57, 4, v57
    v_lshl_or_b32 v7, v56, 8, v57
    s_lshl_b32 s61, s58, 11
    buffer_load_dwordx4 v[168:171], v7, s[16:19], s61 offen offset:0
    buffer_load_dwordx4 v[172:175], v7, s[16:19], s61 offen offset:64
    buffer_load_dwordx4 v[176:179], v7, s[16:19], s61 offen offset:128
    buffer_load_dwordx4 v[180:183], v7, s[16:19], s61 offen offset:192
    s_add_u32 m0, s55, 8192
    s_nop 0
    buffer_load_dwordx4 v2, s[8:11], s46 offen offset:0 lds
    buffer_load_dwordx4 v3, s[8:11], s46 offen offset:1024 lds
    buffer_load_dwordx4 v4, s[8:11], s46 offen offset:2048 lds
    buffer_load_dwordx4 v5, s[8:11], s46 offen offset:3072 lds
    s_add_u32 m0, s55, 12288
    s_nop 0
    buffer_load_dwordx4 v2, s[8:11], s47 offen offset:0 lds
    buffer_load_dwordx4 v3, s[8:11], s47 offen offset:1024 lds
    buffer_load_dwordx4 v4, s[8:11], s47 offen offset:2048 lds
    buffer_load_dwordx4 v5, s[8:11], s47 offen offset:3072 lds
    s_add_u32 m0, s55, 16384
    s_nop 0
    buffer_load_dwordx4 v2, s[8:11], s48 offen offset:0 lds
    buffer_load_dwordx4 v3, s[8:11], s48 offen offset:1024 lds
    buffer_load_dwordx4 v4, s[8:11], s48 offen offset:2048 lds
    buffer_load_dwordx4 v5, s[8:11], s48 offen offset:3072 lds
    s_add_u32 m0, s55, 20480
    s_nop 0
    buffer_load_dwordx4 v2, s[8:11], s49 offen offset:0 lds
    buffer_load_dwordx4 v3, s[8:11], s49 offen offset:1024 lds
    buffer_load_dwordx4 v4, s[8:11], s49 offen offset:2048 lds
    buffer_load_dwordx4 v5, s[8:11], s49 offen offset:3072 lds
    s_add_u32 m0, s55, 24576
    s_nop 0
    buffer_load_dwordx4 v2, s[8:11], s50 offen offset:0 lds
    buffer_load_dwordx4 v3, s[8:11], s50 offen offset:1024 lds
    buffer_load_dwordx4 v4, s[8:11], s50 offen offset:2048 lds
    buffer_load_dwordx4 v5, s[8:11], s50 offen offset:3072 lds
    s_add_u32 m0, s55, 28672
    s_nop 0
    buffer_load_dwordx4 v2, s[8:11], s51 offen offset:0 lds
    buffer_load_dwordx4 v3, s[8:11], s51 offen offset:1024 lds
    buffer_load_dwordx4 v4, s[8:11], s51 offen offset:2048 lds
    buffer_load_dwordx4 v5, s[8:11], s51 offen offset:3072 lds
    buffer_load_dwordx4 v[104:107], v6, s[12:15], s44 offen offset:0
    buffer_load_dwordx4 v[108:111], v6, s[12:15], s44 offen offset:1024
    s_mov_b32 s52, 0x3e0293ee
    s_mov_b32 s53, 0x05040100
    s_mov_b32 s54, 0x07060302
    s_mov_b32 s56, 0xff00ff00
    s_mov_b32 s57, 0xff00ff00
    v_mov_b32 v52, 0x3f803f80
    v_mov_b32 v53, 0x3f803f80
    v_mov_b32 v54, 0x3f803f80
    v_mov_b32 v55, 0x3f803f80
    v_mov_b32 v60, 0
    v_mov_b32 v61, 0
    v_mov_b32 v62, 0
    v_mov_b32 v63, 0
    v_mov_b32 v64, 0
    v_mov_b32 v65, 0
    v_mov_b32 v66, 0
    v_mov_b32 v67, 0
    v_mov_b32 v68, 0
    v_mov_b32 v69, 0
    v_mov_b32 v70, 0
    v_mov_b32 v71, 0
    v_mov_b32 v72, 0
    v_mov_b32 v73, 0
    v_mov_b32 v74, 0
    v_mov_b32 v75, 0
    v_mov_b32 v76, 0
    v_mov_b32 v77, 0
    v_mov_b32 v78, 0
    v_mov_b32 v79, 0
    v_mov_b32 v80, 0
    v_mov_b32 v81, 0
    v_mov_b32 v82, 0
    v_mov_b32 v83, 0
    v_mov_b32 v84, 0
    v_mov_b32 v85, 0
    v_mov_b32 v86, 0
    v_mov_b32 v87, 0
    v_mov_b32 v88, 0
    v_mov_b32 v89, 0
    v_mov_b32 v90, 0
    v_mov_b32 v91, 0
    v_and_b32 v56, 3, v1
    v_bfe_u32 v57, v1, 2, 2
    v_lshl_or_b32 v56, v56, 2, v57
    v_and_b32 v57, 15, v1
    v_lshrrev_b32 v58, 4, v1
    v_xor_b32 v57, v57, v58
    v_lshlrev_b32 v57, 4, v57
    v_lshl_or_b32 v56, v56, 8, v57
    v_add_u32 v8, s55, v56
    v_xor_b32 v9, 64, v8
    v_xor_b32 v10, 128, v8
    v_xor_b32 v11, 192, v8
    v_and_b32 v56, 7, v1
    v_mul_u32_u24 v56, 528, v56
    v_bfe_u32 v57, v1, 3, 1
    v_lshl_add_u32 v56, v57, 8, v56
    v_lshl_add_u32 v56, v58, 4, v56
    s_mul_i32 s4, s3, 4224
    s_add_u32 s4, s4, 131584
    v_add_u32 v12, s4, v56
    v_lshrrev_b32 v56, 5, v1
    v_and_b32 v57, 31, v1
    v_lshlrev_b32 v57, 4, v57
    v_mul_u32_u24 v58, 528, v56
    v_add_u32 v58, v58, v57
    s_mul_i32 s4, s3, 1056
    s_add_u32 s4, s4, 131584
    v_add_u32 v13, s4, v58
    s_lshl_b32 s4, s3, 5
    s_add_u32 s4, s4, 131328
    v_lshlrev_b32 v58, 4, v56
    v_add_u32 v14, s4, v58
    v_mul_u32_u24 v58, 4224, v56
    v_add_u32 v15, v58, v57
    s_mul_i32 s4, s3, 8448
    s_lshl_b32 s5, s58, 17
    s_add_u32 s4, s4, s5
    s_lshl_b32 s5, s59, 9
    s_add_u32 s62, s4, s5
    s_add_u32 s7, s62, 0x10000
    v_mov_b32 v0, 131456
    s_waitcnt vmcnt(26)
    ds_read_b128 v[200:203], v8 offset:0
    ds_read_b128 v[204:207], v9 offset:0
    ds_read_b128 v[208:211], v10 offset:0
    ds_read_b128 v[212:215], v11 offset:0
    v_cndmask_b32 v184, 0, v168, s[56:57]
    v_cndmask_b32 v185, 0, v169, s[56:57]
    v_cndmask_b32 v186, 0, v170, s[56:57]
    v_cndmask_b32 v187, 0, v171, s[56:57]
    v_cndmask_b32 v188, 0, v172, s[56:57]
    v_cndmask_b32 v189, 0, v173, s[56:57]
    v_cndmask_b32 v190, 0, v174, s[56:57]
    v_cndmask_b32 v191, 0, v175, s[56:57]
    v_cndmask_b32 v192, 0, v176, s[56:57]
    v_cndmask_b32 v193, 0, v177, s[56:57]
    v_cndmask_b32 v194, 0, v178, s[56:57]
    v_cndmask_b32 v195, 0, v179, s[56:57]
    v_cndmask_b32 v196, 0, v180, s[56:57]
    v_cndmask_b32 v197, 0, v181, s[56:57]
    v_cndmask_b32 v198, 0, v182, s[56:57]
    v_cndmask_b32 v199, 0, v183, s[56:57]
    v_cndmask_b32 v168, v168, 0, s[56:57]
    v_cndmask_b32 v169, v169, 0, s[56:57]
    v_cndmask_b32 v170, v170, 0, s[56:57]
    v_cndmask_b32 v171, v171, 0, s[56:57]
    v_cndmask_b32 v172, v172, 0, s[56:57]
    v_cndmask_b32 v173, v173, 0, s[56:57]
    v_cndmask_b32 v174, v174, 0, s[56:57]
    v_cndmask_b32 v175, v175, 0, s[56:57]
    v_cndmask_b32 v176, v176, 0, s[56:57]
    v_cndmask_b32 v177, v177, 0, s[56:57]
    v_cndmask_b32 v178, v178, 0, s[56:57]
    v_cndmask_b32 v179, v179, 0, s[56:57]
    v_cndmask_b32 v180, v180, 0, s[56:57]
    v_cndmask_b32 v181, v181, 0, s[56:57]
    v_cndmask_b32 v182, v182, 0, s[56:57]
    v_cndmask_b32 v183, v183, 0, s[56:57]
    buffer_load_dwordx4 v[112:115], v6, s[12:15], s44 offen offset:2048
    buffer_load_dwordx4 v[116:119], v6, s[12:15], s44 offen offset:3072
    s_waitcnt vmcnt(32)
    s_mov_b64 exec, 1
    ds_write_b32 v0, v0
    s_mov_b64 exec, -1
    ds_read_b128 v[216:219], v8 offset:4096
    ds_read_b128 v[220:223], v9 offset:4096
    ds_read_b128 v[224:227], v10 offset:4096
    ds_read_b128 v[228:231], v11 offset:4096
    buffer_load_dwordx4 v[120:123], v6, s[12:15], s45 offen offset:0
    buffer_load_dwordx4 v[124:127], v6, s[12:15], s45 offen offset:1024
    s_waitcnt lgkmcnt(4)
    v_mfma_f32_16x16x32_bf16 v[16:19], v[200:203], v[168:171], 0
    v_mfma_f32_16x16x32_bf16 v[16:19], v[204:207], v[172:175], v[16:19]
    v_mfma_f32_16x16x32_bf16 v[16:19], v[208:211], v[176:179], v[16:19]
    v_mfma_f32_16x16x32_bf16 v[16:19], v[212:215], v[180:183], v[16:19]
    s_waitcnt vmcnt(26)
    ds_read_b128 v[200:203], v8 offset:8192
    ds_read_b128 v[204:207], v9 offset:8192
    ds_read_b128 v[208:211], v10 offset:8192
    ds_read_b128 v[212:215], v11 offset:8192
    buffer_load_dwordx4 v[128:131], v6, s[12:15], s45 offen offset:2048
    buffer_load_dwordx4 v[132:135], v6, s[12:15], s45 offen offset:3072
    s_waitcnt lgkmcnt(4)
    v_mfma_f32_16x16x32_bf16 v[16:19], v[216:219], v[184:187], v[16:19]
    v_mfma_f32_16x16x32_bf16 v[16:19], v[220:223], v[188:191], v[16:19]
    v_mfma_f32_16x16x32_bf16 v[16:19], v[224:227], v[192:195], v[16:19]
    v_mfma_f32_16x16x32_bf16 v[16:19], v[228:231], v[196:199], v[16:19]
    s_waitcnt vmcnt(24)
    ds_read_b128 v[216:219], v8 offset:12288
    ds_read_b128 v[220:223], v9 offset:12288
    ds_read_b128 v[224:227], v10 offset:12288
    ds_read_b128 v[228:231], v11 offset:12288
    buffer_load_dwordx4 v[136:139], v6, s[12:15], s46 offen offset:0
    buffer_load_dwordx4 v[140:143], v6, s[12:15], s46 offen offset:1024
    s_waitcnt lgkmcnt(4)
    v_mfma_f32_16x16x32_bf16 v[20:23], v[200:203], v[168:171], 0
    v_mfma_f32_16x16x32_bf16 v[20:23], v[204:207], v[172:175], v[20:23]
    v_mfma_f32_16x16x32_bf16 v[20:23], v[208:211], v[176:179], v[20:23]
    v_mfma_f32_16x16x32_bf16 v[20:23], v[212:215], v[180:183], v[20:23]
    s_waitcnt vmcnt(22)
    ds_read_b128 v[200:203], v8 offset:16384
    ds_read_b128 v[204:207], v9 offset:16384
    ds_read_b128 v[208:211], v10 offset:16384
    ds_read_b128 v[212:215], v11 offset:16384
    buffer_load_dwordx4 v[144:147], v6, s[12:15], s46 offen offset:2048
    buffer_load_dwordx4 v[148:151], v6, s[12:15], s46 offen offset:3072
    s_waitcnt lgkmcnt(4)
    v_mfma_f32_16x16x32_bf16 v[20:23], v[216:219], v[184:187], v[20:23]
    v_mfma_f32_16x16x32_bf16 v[20:23], v[220:223], v[188:191], v[20:23]
    v_mfma_f32_16x16x32_bf16 v[20:23], v[224:227], v[192:195], v[20:23]
    v_mfma_f32_16x16x32_bf16 v[20:23], v[228:231], v[196:199], v[20:23]
    s_waitcnt vmcnt(20)
    ds_read_b128 v[216:219], v8 offset:20480
    ds_read_b128 v[220:223], v9 offset:20480
    ds_read_b128 v[224:227], v10 offset:20480
    ds_read_b128 v[228:231], v11 offset:20480
    buffer_load_dwordx4 v[152:155], v6, s[12:15], s47 offen offset:0
    buffer_load_dwordx4 v[156:159], v6, s[12:15], s47 offen offset:1024
    s_waitcnt lgkmcnt(4)
    v_mfma_f32_16x16x32_bf16 v[24:27], v[200:203], v[168:171], 0
    v_mfma_f32_16x16x32_bf16 v[24:27], v[204:207], v[172:175], v[24:27]
    v_mfma_f32_16x16x32_bf16 v[24:27], v[208:211], v[176:179], v[24:27]
    v_mfma_f32_16x16x32_bf16 v[24:27], v[212:215], v[180:183], v[24:27]
    s_waitcnt vmcnt(18)
    ds_read_b128 v[200:203], v8 offset:24576
    ds_read_b128 v[204:207], v9 offset:24576
    ds_read_b128 v[208:211], v10 offset:24576
    ds_read_b128 v[212:215], v11 offset:24576
    buffer_load_dwordx4 v[160:163], v6, s[12:15], s47 offen offset:2048
    buffer_load_dwordx4 v[164:167], v6, s[12:15], s47 offen offset:3072
    s_waitcnt lgkmcnt(4)
    v_mfma_f32_16x16x32_bf16 v[24:27], v[216:219], v[184:187], v[24:27]
    v_mfma_f32_16x16x32_bf16 v[24:27], v[220:223], v[188:191], v[24:27]
    v_mfma_f32_16x16x32_bf16 v[24:27], v[224:227], v[192:195], v[24:27]
    v_mfma_f32_16x16x32_bf16 v[24:27], v[228:231], v[196:199], v[24:27]
    s_waitcnt vmcnt(16)
    ds_read_b128 v[216:219], v8 offset:28672
    ds_read_b128 v[220:223], v9 offset:28672
    ds_read_b128 v[224:227], v10 offset:28672
    ds_read_b128 v[228:231], v11 offset:28672
    s_waitcnt lgkmcnt(4)
    v_mfma_f32_16x16x32_bf16 v[28:31], v[200:203], v[168:171], 0
    v_mfma_f32_16x16x32_bf16 v[28:31], v[204:207], v[172:175], v[28:31]
    v_mfma_f32_16x16x32_bf16 v[28:31], v[208:211], v[176:179], v[28:31]
    v_mfma_f32_16x16x32_bf16 v[28:31], v[212:215], v[180:183], v[28:31]
    s_waitcnt lgkmcnt(0)
    v_mfma_f32_16x16x32_bf16 v[28:31], v[216:219], v[184:187], v[28:31]
    v_mfma_f32_16x16x32_bf16 v[28:31], v[220:223], v[188:191], v[28:31]
    v_mfma_f32_16x16x32_bf16 v[28:31], v[224:227], v[192:195], v[28:31]
    v_mfma_f32_16x16x32_bf16 v[28:31], v[228:231], v[196:199], v[28:31]
    v_max3_f32 v56, v16, v17, v18
    v_max3_f32 v57, v19, v20, v21
    v_max3_f32 v56, v56, v22, v23
    v_max3_f32 v57, v57, v24, v25
    v_max3_f32 v56, v56, v26, v27
    s_nop 2
    v_max3_f32 v57, v57, v28, v29
    v_max3_f32 v56, v56, v30, v31
    v_max_f32 v56, v56, v57
    s_nop 1
    v_max_f32_dpp v56, v56, v56 row_ror:8 row_mask:0xf bank_mask:0xf
    v_mov_b32 v57, v56
    s_nop 1
    v_permlane16_swap_b32 v56, v57
    v_max_f32 v56, v56, v57
    v_mov_b32 v57, v56
    s_nop 1
    v_permlane32_swap_b32 v56, v57
    v_max_f32 v56, v56, v57
    v_mul_f32 v58, s52, v56
    v_fma_f32 v16, v16, s52, -v58
    v_fma_f32 v17, v17, s52, -v58
    v_fma_f32 v18, v18, s52, -v58
    v_fma_f32 v19, v19, s52, -v58
    v_fma_f32 v20, v20, s52, -v58
    v_fma_f32 v21, v21, s52, -v58
    v_fma_f32 v22, v22, s52, -v58
    v_fma_f32 v23, v23, s52, -v58
    v_fma_f32 v24, v24, s52, -v58
    v_fma_f32 v25, v25, s52, -v58
    v_fma_f32 v26, v26, s52, -v58
    v_fma_f32 v27, v27, s52, -v58
    v_fma_f32 v28, v28, s52, -v58
    v_fma_f32 v29, v29, s52, -v58
    v_fma_f32 v30, v30, s52, -v58
    v_fma_f32 v31, v31, s52, -v58
    v_exp_f32 v16, v16
    v_exp_f32 v17, v17
    v_exp_f32 v18, v18
    v_exp_f32 v19, v19
    v_exp_f32 v20, v20
    v_exp_f32 v21, v21
    v_exp_f32 v22, v22
    v_exp_f32 v23, v23
    v_exp_f32 v24, v24
    v_exp_f32 v25, v25
    v_exp_f32 v26, v26
    v_exp_f32 v27, v27
    v_exp_f32 v28, v28
    v_exp_f32 v29, v29
    v_exp_f32 v30, v30
    v_exp_f32 v31, v31
    s_not_b64 exec, s[56:57]
    v_cvt_pk_bf16_f32 v60, v16, v17
    v_cvt_pk_bf16_f32 v61, v18, v19
    v_cvt_pk_bf16_f32 v68, v20, v21
    v_cvt_pk_bf16_f32 v69, v22, v23
    v_cvt_pk_bf16_f32 v76, v24, v25
    v_cvt_pk_bf16_f32 v77, v26, v27
    v_cvt_pk_bf16_f32 v84, v28, v29
    v_cvt_pk_bf16_f32 v85, v30, v31
    s_mov_b64 exec, s[56:57]
    v_cvt_pk_bf16_f32 v66, v16, v17
    v_cvt_pk_bf16_f32 v67, v18, v19
    v_cvt_pk_bf16_f32 v74, v20, v21
    v_cvt_pk_bf16_f32 v75, v22, v23
    v_cvt_pk_bf16_f32 v82, v24, v25
    v_cvt_pk_bf16_f32 v83, v26, v27
    v_cvt_pk_bf16_f32 v90, v28, v29
    v_cvt_pk_bf16_f32 v91, v30, v31
    s_mov_b64 exec, -1
    v_mov_b32_dpp v62, v66 row_ror:8 row_mask:0xf bank_mask:0x3
    v_mov_b32_dpp v63, v67 row_ror:8 row_mask:0xf bank_mask:0x3
    v_mov_b32_dpp v70, v74 row_ror:8 row_mask:0xf bank_mask:0x3
    v_mov_b32_dpp v71, v75 row_ror:8 row_mask:0xf bank_mask:0x3
    v_mov_b32_dpp v78, v82 row_ror:8 row_mask:0xf bank_mask:0x3
    v_mov_b32_dpp v79, v83 row_ror:8 row_mask:0xf bank_mask:0x3
    v_mov_b32_dpp v86, v90 row_ror:8 row_mask:0xf bank_mask:0x3
    v_mov_b32_dpp v87, v91 row_ror:8 row_mask:0xf bank_mask:0x3
    v_mov_b32_dpp v64, v60 row_ror:8 row_mask:0xf bank_mask:0xc
    v_mov_b32_dpp v65, v61 row_ror:8 row_mask:0xf bank_mask:0xc
    v_mov_b32_dpp v72, v68 row_ror:8 row_mask:0xf bank_mask:0xc
    v_mov_b32_dpp v73, v69 row_ror:8 row_mask:0xf bank_mask:0xc
    v_mov_b32_dpp v80, v76 row_ror:8 row_mask:0xf bank_mask:0xc
    v_mov_b32_dpp v81, v77 row_ror:8 row_mask:0xf bank_mask:0xc
    v_mov_b32_dpp v88, v84 row_ror:8 row_mask:0xf bank_mask:0xc
    v_mov_b32_dpp v89, v85 row_ror:8 row_mask:0xf bank_mask:0xc
    v_mfma_f32_16x16x32_bf16 v[48:51], v[52:55], v[60:63], 0
    v_mfma_f32_16x16x32_bf16 v[48:51], v[52:55], v[68:71], v[48:51]
    v_mfma_f32_16x16x32_bf16 v[48:51], v[52:55], v[76:79], v[48:51]
    v_mfma_f32_16x16x32_bf16 v[48:51], v[52:55], v[84:87], v[48:51]
    buffer_load_dwordx4 v[168:171], v6, s[12:15], s48 offen offset:0
    buffer_load_dwordx4 v[172:175], v6, s[12:15], s48 offen offset:1024
    buffer_load_dwordx4 v[176:179], v6, s[12:15], s48 offen offset:2048
    buffer_load_dwordx4 v[180:183], v6, s[12:15], s48 offen offset:3072
    buffer_load_dwordx4 v[184:187], v6, s[12:15], s49 offen offset:0
    buffer_load_dwordx4 v[188:191], v6, s[12:15], s49 offen offset:1024
    buffer_load_dwordx4 v[192:195], v6, s[12:15], s49 offen offset:2048
    buffer_load_dwordx4 v[196:199], v6, s[12:15], s49 offen offset:3072
    buffer_load_dwordx4 v[200:203], v6, s[12:15], s50 offen offset:0
    buffer_load_dwordx4 v[204:207], v6, s[12:15], s50 offen offset:1024
    buffer_load_dwordx4 v[208:211], v6, s[12:15], s50 offen offset:2048
    buffer_load_dwordx4 v[212:215], v6, s[12:15], s50 offen offset:3072
    buffer_load_dwordx4 v[216:219], v6, s[12:15], s51 offen offset:0
    buffer_load_dwordx4 v[220:223], v6, s[12:15], s51 offen offset:1024
    buffer_load_dwordx4 v[224:227], v6, s[12:15], s51 offen offset:2048
    buffer_load_dwordx4 v[228:231], v6, s[12:15], s51 offen offset:3072
    v_lshlrev_b32 v57, 5, v1
    s_lshl_b32 s4, s3, 3
    s_add_u32 s4, s4, 131072
    v_add_u32 v57, s4, v57
    v_min_u32 v58, -2, v58
    v_min_u32 v59, -2, v48
    s_mov_b64 exec, 0xff
    ds_write_b64 v57, v[58:59]
    s_mov_b64 exec, -1
    s_add_u32 s65, s64, 1
    s_mov_b32 s66, 0x07060500
    s_mov_b32 s67, 0x07060501
    s_mov_b32 s68, 0x07060502
    s_mov_b32 s69, 0x07060503
    v_mov_b32 v56, s65
    s_waitcnt vmcnt(24)
    v_perm_b32 v92, v108, v104, s53
    v_perm_b32 v93, v116, v112, s53
    v_perm_b32 v94, v124, v120, s53
    v_perm_b32 v95, v132, v128, s53
    v_perm_b32 v96, v108, v104, s54
    v_perm_b32 v97, v116, v112, s54
    v_perm_b32 v98, v124, v120, s54
    v_perm_b32 v99, v132, v128, s54
    v_mfma_f32_16x16x32_bf16 v[32:35], v[92:95], v[60:63], 0
    v_perm_b32 v100, v109, v105, s53
    v_perm_b32 v101, v117, v113, s53
    v_perm_b32 v102, v125, v121, s53
    v_perm_b32 v103, v133, v129, s53
    v_mfma_f32_16x16x32_bf16 v[36:39], v[96:99], v[60:63], 0
    v_perm_b32 v92, v109, v105, s54
    v_perm_b32 v93, v117, v113, s54
    v_perm_b32 v94, v125, v121, s54
    v_perm_b32 v95, v133, v129, s54
    v_mfma_f32_16x16x32_bf16 v[40:43], v[100:103], v[60:63], 0
    v_perm_b32 v96, v110, v106, s53
    v_perm_b32 v97, v118, v114, s53
    v_perm_b32 v98, v126, v122, s53
    v_perm_b32 v99, v134, v130, s53
    v_mfma_f32_16x16x32_bf16 v[44:47], v[92:95], v[60:63], 0
    v_perm_b32 v100, v110, v106, s54
    v_perm_b32 v101, v118, v114, s54
    v_perm_b32 v102, v126, v122, s54
    v_perm_b32 v103, v134, v130, s54
    v_mfma_f32_16x16x32_bf16 v[32:35], v[96:99], v[64:67], v[32:35]
    v_perm_b32 v92, v111, v107, s53
    v_perm_b32 v93, v119, v115, s53
    v_perm_b32 v94, v127, v123, s53
    v_perm_b32 v95, v135, v131, s53
    v_mfma_f32_16x16x32_bf16 v[36:39], v[100:103], v[64:67], v[36:39]
    v_perm_b32 v96, v111, v107, s54
    v_perm_b32 v97, v119, v115, s54
    v_perm_b32 v98, v127, v123, s54
    v_perm_b32 v99, v135, v131, s54
    v_mfma_f32_16x16x32_bf16 v[40:43], v[92:95], v[64:67], v[40:43]
    s_nop 0
    v_mfma_f32_16x16x32_bf16 v[44:47], v[96:99], v[64:67], v[44:47]
    s_waitcnt vmcnt(16)
    v_perm_b32 v92, v140, v136, s53
    v_perm_b32 v93, v148, v144, s53
    v_perm_b32 v94, v156, v152, s53
    v_perm_b32 v95, v164, v160, s53
    v_perm_b32 v96, v140, v136, s54
    v_perm_b32 v97, v148, v144, s54
    v_perm_b32 v98, v156, v152, s54
    v_perm_b32 v99, v164, v160, s54
    v_mfma_f32_16x16x32_bf16 v[32:35], v[92:95], v[68:71], v[32:35]
    v_perm_b32 v100, v141, v137, s53
    v_perm_b32 v101, v149, v145, s53
    v_perm_b32 v102, v157, v153, s53
    v_perm_b32 v103, v165, v161, s53
    v_mfma_f32_16x16x32_bf16 v[36:39], v[96:99], v[68:71], v[36:39]
    v_perm_b32 v92, v141, v137, s54
    v_perm_b32 v93, v149, v145, s54
    v_perm_b32 v94, v157, v153, s54
    v_perm_b32 v95, v165, v161, s54
    v_mfma_f32_16x16x32_bf16 v[40:43], v[100:103], v[68:71], v[40:43]
    v_perm_b32 v96, v142, v138, s53
    v_perm_b32 v97, v150, v146, s53
    v_perm_b32 v98, v158, v154, s53
    v_perm_b32 v99, v166, v162, s53
    v_mfma_f32_16x16x32_bf16 v[44:47], v[92:95], v[68:71], v[44:47]
    v_perm_b32 v100, v142, v138, s54
    v_perm_b32 v101, v150, v146, s54
    v_perm_b32 v102, v158, v154, s54
    v_perm_b32 v103, v166, v162, s54
    v_mfma_f32_16x16x32_bf16 v[32:35], v[96:99], v[72:75], v[32:35]
    v_perm_b32 v92, v143, v139, s53
    v_perm_b32 v93, v151, v147, s53
    v_perm_b32 v94, v159, v155, s53
    v_perm_b32 v95, v167, v163, s53
    v_mfma_f32_16x16x32_bf16 v[36:39], v[100:103], v[72:75], v[36:39]
    v_perm_b32 v96, v143, v139, s54
    v_perm_b32 v97, v151, v147, s54
    v_perm_b32 v98, v159, v155, s54
    v_perm_b32 v99, v167, v163, s54
    v_mfma_f32_16x16x32_bf16 v[40:43], v[92:95], v[72:75], v[40:43]
    s_nop 0
    v_mfma_f32_16x16x32_bf16 v[44:47], v[96:99], v[72:75], v[44:47]
    s_waitcnt vmcnt(8)
    v_perm_b32 v92, v172, v168, s53
    v_perm_b32 v93, v180, v176, s53
    v_perm_b32 v94, v188, v184, s53
    v_perm_b32 v95, v196, v192, s53
    v_perm_b32 v96, v172, v168, s54
    v_perm_b32 v97, v180, v176, s54
    v_perm_b32 v98, v188, v184, s54
    v_perm_b32 v99, v196, v192, s54
    v_mfma_f32_16x16x32_bf16 v[32:35], v[92:95], v[76:79], v[32:35]
    v_perm_b32 v100, v173, v169, s53
    v_perm_b32 v101, v181, v177, s53
    v_perm_b32 v102, v189, v185, s53
    v_perm_b32 v103, v197, v193, s53
    v_mfma_f32_16x16x32_bf16 v[36:39], v[96:99], v[76:79], v[36:39]
    v_perm_b32 v92, v173, v169, s54
    v_perm_b32 v93, v181, v177, s54
    v_perm_b32 v94, v189, v185, s54
    v_perm_b32 v95, v197, v193, s54
    v_mfma_f32_16x16x32_bf16 v[40:43], v[100:103], v[76:79], v[40:43]
    v_perm_b32 v96, v174, v170, s53
    v_perm_b32 v97, v182, v178, s53
    v_perm_b32 v98, v190, v186, s53
    v_perm_b32 v99, v198, v194, s53
    v_mfma_f32_16x16x32_bf16 v[44:47], v[92:95], v[76:79], v[44:47]
    v_perm_b32 v100, v174, v170, s54
    v_perm_b32 v101, v182, v178, s54
    v_perm_b32 v102, v190, v186, s54
    v_perm_b32 v103, v198, v194, s54
    v_mfma_f32_16x16x32_bf16 v[32:35], v[96:99], v[80:83], v[32:35]
    v_perm_b32 v92, v175, v171, s53
    v_perm_b32 v93, v183, v179, s53
    v_perm_b32 v94, v191, v187, s53
    v_perm_b32 v95, v199, v195, s53
    v_mfma_f32_16x16x32_bf16 v[36:39], v[100:103], v[80:83], v[36:39]
    v_perm_b32 v96, v175, v171, s54
    v_perm_b32 v97, v183, v179, s54
    v_perm_b32 v98, v191, v187, s54
    v_perm_b32 v99, v199, v195, s54
    v_mfma_f32_16x16x32_bf16 v[40:43], v[92:95], v[80:83], v[40:43]
    s_nop 0
    v_mfma_f32_16x16x32_bf16 v[44:47], v[96:99], v[80:83], v[44:47]
    s_waitcnt vmcnt(6)
    v_perm_b32 v104, v204, v200, s53
    v_perm_b32 v108, v204, v200, s54
    v_perm_b32 v112, v205, v201, s53
    v_perm_b32 v116, v205, v201, s54
    v_perm_b32 v120, v206, v202, s53
    v_perm_b32 v124, v206, v202, s54
    v_perm_b32 v128, v207, v203, s53
    v_perm_b32 v132, v207, v203, s54
    s_waitcnt vmcnt(4)
    v_perm_b32 v105, v212, v208, s53
    v_perm_b32 v109, v212, v208, s54
    v_perm_b32 v113, v213, v209, s53
    v_perm_b32 v117, v213, v209, s54
    v_perm_b32 v121, v214, v210, s53
    v_perm_b32 v125, v214, v210, s54
    v_perm_b32 v129, v215, v211, s53
    v_perm_b32 v133, v215, v211, s54
    s_waitcnt vmcnt(2)
    v_perm_b32 v106, v220, v216, s53
    v_perm_b32 v110, v220, v216, s54
    v_perm_b32 v114, v221, v217, s53
    v_perm_b32 v118, v221, v217, s54
    v_perm_b32 v122, v222, v218, s53
    v_perm_b32 v126, v222, v218, s54
    v_perm_b32 v130, v223, v219, s53
    v_perm_b32 v134, v223, v219, s54
    s_waitcnt vmcnt(0)
    v_perm_b32 v107, v228, v224, s53
    v_perm_b32 v111, v228, v224, s54
    v_perm_b32 v115, v229, v225, s53
    v_mfma_f32_16x16x32_bf16 v[32:35], v[104:107], v[84:87], v[32:35]
    v_perm_b32 v119, v229, v225, s54
    v_mfma_f32_16x16x32_bf16 v[36:39], v[108:111], v[84:87], v[36:39]
    v_perm_b32 v123, v230, v226, s53
    v_mfma_f32_16x16x32_bf16 v[40:43], v[112:115], v[84:87], v[40:43]
    v_perm_b32 v127, v230, v226, s54
    v_mfma_f32_16x16x32_bf16 v[44:47], v[116:119], v[84:87], v[44:47]
    v_perm_b32 v131, v231, v227, s53
    v_mfma_f32_16x16x32_bf16 v[32:35], v[120:123], v[88:91], v[32:35]
    v_perm_b32 v135, v231, v227, s54
    v_mfma_f32_16x16x32_bf16 v[36:39], v[124:127], v[88:91], v[36:39]
    v_mfma_f32_16x16x32_bf16 v[40:43], v[128:131], v[88:91], v[40:43]
    v_mfma_f32_16x16x32_bf16 v[44:47], v[132:135], v[88:91], v[44:47]
    s_nop 3
    ds_write_b128 v12, v[32:35] offset:0
    s_nop 0
    ds_write_b128 v12, v[36:39] offset:64
    ds_write_b128 v12, v[40:43] offset:128
    ds_write_b128 v12, v[44:47] offset:192
    s_waitcnt lgkmcnt(0)
    s_barrier
    ds_read_b128 v[48:51], v14
    ds_read_b128 v[16:19], v13 offset:0
    ds_read_b128 v[20:23], v13 offset:4224
    ds_read_b128 v[24:27], v13 offset:8448
    ds_read_b128 v[28:31], v13 offset:12672
    s_waitcnt lgkmcnt(3)
    v_pk_mul_f32 v[16:17], v[16:17], v[48:49] op_sel:[0,0] op_sel_hi:[1,0]
    v_pk_mul_f32 v[18:19], v[18:19], v[48:49] op_sel:[0,0] op_sel_hi:[1,0]
    s_waitcnt lgkmcnt(2)
    v_pk_fma_f32 v[16:17], v[20:21], v[48:49], v[16:17] op_sel:[0,1,0] op_sel_hi:[1,1,1]
    v_pk_fma_f32 v[18:19], v[22:23], v[48:49], v[18:19] op_sel:[0,1,0] op_sel_hi:[1,1,1]
    s_waitcnt lgkmcnt(1)
    v_pk_fma_f32 v[16:17], v[24:25], v[50:51], v[16:17] op_sel:[0,0,0] op_sel_hi:[1,0,1]
    v_pk_fma_f32 v[18:19], v[26:27], v[50:51], v[18:19] op_sel:[0,0,0] op_sel_hi:[1,0,1]
    s_waitcnt lgkmcnt(0)
    v_pk_fma_f32 v[16:17], v[28:29], v[50:51], v[16:17] op_sel:[0,1,0] op_sel_hi:[1,1,1]
    v_pk_fma_f32 v[18:19], v[30:31], v[50:51], v[18:19] op_sel:[0,1,0] op_sel_hi:[1,1,1]
    v_perm_b32 v16, v16, v56, s66
    v_perm_b32 v17, v17, v56, s67
    v_perm_b32 v18, v18, v56, s68
    v_perm_b32 v19, v19, v56, s69
    buffer_store_dwordx4 v[16:19], v15, s[20:23], s7 offen
    buffer_store_dwordx4 v[16:19], v15, s[20:23], s62 offen sc1
    s_endpgm
L_CTRL:
    s_setprio 3
    s_load_dwordx2 s[32:33], s[0:1], 24
    s_load_dwordx2 s[36:37], s[0:1], 32
    s_load_dwordx2 s[40:41], s[0:1], 40
    s_load_dwordx2 s[24:25], s[0:1], 48
    s_mov_b32 s34, 0x2000
    s_mov_b32 s35, 0x20000
    s_mov_b32 s38, 0x2000
    s_mov_b32 s39, 0x20000
    s_mov_b32 s42, 0x10
    s_mov_b32 s43, 0x20000
    s_mov_b32 s26, 0x10000
    s_mov_b32 s27, 0x20000
    s_getreg_b32 s7, hwreg(HW_REG_XCC_ID, 0, 4)
    v_mov_b32 v8, -1
    v_lshlrev_b32 v5, 2, v1
    v_add_u32 v5, 131072, v5
    ds_write_b32 v5, v8
    ds_write_b32 v5, v8 offset:256
    v_lshrrev_b32 v2, 5, v1
    v_and_b32 v3, 31, v1
    s_lshl_b32 s63, s58, 17
    s_add_u32 s63, s63, 0xC000
    s_mul_i32 s61, s58, 131072
    s_lshl_b32 s4, s59, 4
    s_add_u32 s61, s61, s4
    s_add_u32 s61, s61, 4096
    s_waitcnt lgkmcnt(0)
    s_buffer_load_dword s64, s[20:23], s63
    s_barrier
    v_and_b32 v5, 3, v3
    v_lshlrev_b32 v5, 1, v5
    v_add_u32 v5, v5, v2
    v_lshrrev_b32 v18, 2, v3
    v_lshl_add_u32 v5, v5, 4, v18
    v_lshlrev_b32 v17, 1, v5
    v_lshlrev_b32 v19, 2, v1
    v_mov_b32 v18, 0
    s_mov_b32 s52, 0x3e0293ee
    v_lshlrev_b32 v6, 4, v3
    v_lshl_add_u32 v22, v2, 11, v6
    v_lshl_add_u32 v6, v2, 2, v1
    v_and_b32 v6, 7, v6
    v_lshlrev_b32 v6, 4, v6
    v_add_u32 v23, 69632, v6
    v_add_u32 v8, 0x10000, v22
    v_add_u32 v9, 0x10000, v22
    v_add_u32 v10, 0x10000, v22
    v_add_u32 v11, 0x10000, v22
    v_lshlrev_b32 v6, 3, v3
    v_add_u32 v24, 131072, v6
    v_lshlrev_b32 v6, 2, v3
    v_add_u32 v25, 131328, v6
    v_lshrrev_b32 v6, 2, v3
    v_mul_u32_u24 v7, 4224, v6
    s_mul_i32 s62, s59, 4224
    s_lshl_b32 s4, s58, 17
    s_add_u32 s62, s62, s4
    s_mov_b32 s56, 0
    s_mov_b32 s57, -1
    v_mov_b32 v6, 131456
    s_mov_b32 s60, 0x40000
L_SPIN0:
    ds_read_b32 v28, v6
    s_waitcnt lgkmcnt(0)
    v_cmp_eq_u32 vcc, -1, v28
    s_cbranch_vccz L_GOT0
    s_sleep 2
    s_sub_u32 s60, s60, 1
    s_cbranch_scc0 L_SPIN0
L_GOT0:
    buffer_load_dwordx4 v[36:39], v23, s[20:23], s62 offen sc1
    buffer_load_dwordx4 v[40:43], v8, s[20:23], s62 offen offset:0 sc1
    buffer_load_dwordx4 v[44:47], v9, s[20:23], s62 offen offset:512 sc1
    buffer_load_dwordx4 v[48:51], v10, s[20:23], s62 offen offset:1024 sc1
    buffer_load_dwordx4 v[52:55], v11, s[20:23], s62 offen offset:1536 sc1
    s_mov_b32 s60, 0x40000
L_SPIN:
    ds_read_b64 v[28:29], v24
    s_waitcnt lgkmcnt(0)
    v_max_u32 v6, v28, v29
    v_cmp_eq_u32 vcc, -1, v6
    s_cbranch_vccz L_GOT
    s_sleep 2
    s_sub_u32 s60, s60, 1
    s_cbranch_scc0 L_SPIN
L_GOT:
    s_add_u32 s65, s64, 1
    v_max_f32_dpp v32, v28, v28 quad_perm:[1,0,3,2] row_mask:0xf bank_mask:0xf
    v_mov_b32 v34, s65
    s_nop 0
    v_max_f32_dpp v32, v32, v32 quad_perm:[2,3,0,1] row_mask:0xf bank_mask:0xf
    v_not_b32 v21, v34
    v_xor_b32 v35, s7, v21
    v_sub_f32 v30, v28, v32
    v_exp_f32 v30, v30
    s_nop 0
    v_mul_f32 v33, v30, v29
    ds_write_b32 v25, v30
    s_nop 0
    v_add_f32_dpp v33, v33, v33 quad_perm:[1,0,3,2] row_mask:0xf bank_mask:0xf
    s_nop 1
    v_add_f32_dpp v33, v33, v33 quad_perm:[2,3,0,1] row_mask:0xf bank_mask:0xf
    s_bfe_u32 s66, s65, 0x80000
    s_bfe_u32 s67, s65, 0x80008
    s_bfe_u32 s68, s65, 0x80010
    s_bfe_u32 s69, s65, 0x80018
    s_add_u32 s6, s61, 0x10000
    s_mov_b64 exec, 0x11111111
    buffer_store_dwordx4 v[32:35], v7, s[20:23], s6 offen
    buffer_store_dwordx4 v[32:35], v7, s[20:23], s61 offen sc1
    s_mov_b64 exec, -1
    s_lshl_b32 s4, s2, 8
    buffer_load_dword v12, v19, s[16:19], s4 offen
    s_lshl_b32 s5, s58, 8
    buffer_load_dword v13, v19, s[32:35], s5 offen
    s_lshr_b32 s4, s58, 2
    s_lshl_b32 s4, s4, 1
    buffer_load_ushort v14, v18, s[40:43], s4 offen
    buffer_load_ushort v15, v17, s[36:39], s5 offen
    buffer_load_ushort v16, v17, s[36:39], s5 offen offset:16
    s_waitcnt lgkmcnt(0)
    s_barrier
    buffer_load_dwordx4 v[36:39], v23, s[20:23], s62 offen sc1
    buffer_load_dwordx4 v[40:43], v8, s[20:23], s62 offen offset:0 sc1
    buffer_load_dwordx4 v[44:47], v9, s[20:23], s62 offen offset:512 sc1
    buffer_load_dwordx4 v[48:51], v10, s[20:23], s62 offen offset:1024 sc1
    buffer_load_dwordx4 v[52:55], v11, s[20:23], s62 offen offset:1536 sc1
    s_mov_b32 s60, 0x10000
    s_waitcnt vmcnt(5)
    v_lshlrev_b32 v5, 16, v12
    v_and_b32 v12, 0xffff0000, v12
    v_lshlrev_b32 v6, 16, v13
    v_and_b32 v13, 0xffff0000, v13
    v_mul_f32 v5, v5, v6
    v_fmac_f32 v5, v12, v13
    s_nop 1
    v_add_f32_dpp v5, v5, v5 row_shr:1 row_mask:0xf bank_mask:0xf bound_ctrl:0
    s_nop 1
    v_add_f32_dpp v5, v5, v5 row_shr:2 row_mask:0xf bank_mask:0xf bound_ctrl:0
    s_nop 1
    v_add_f32_dpp v5, v5, v5 row_shr:4 row_mask:0xf bank_mask:0xf bound_ctrl:0
    s_nop 1
    v_add_f32_dpp v5, v5, v5 row_shr:8 row_mask:0xf bank_mask:0xf bound_ctrl:0
    s_nop 1
    v_add_f32_dpp v5, v5, v5 row_bcast:15 row_mask:0xa bank_mask:0xf
    s_nop 1
    v_add_f32_dpp v5, v5, v5 row_bcast:31 row_mask:0xc bank_mask:0xf
    v_lshlrev_b32 v14, 16, v14
    v_sub_f32 v14, 1.0, v14
    v_mul_f32 v14, 0xceabfb8f, v14
    v_readlane_b32 s4, v5, 63
    v_lshlrev_b32 v15, 16, v15
    v_lshlrev_b32 v16, 16, v16
    v_mov_b32 v5, s4
    v_mul_f32 v5, s52, v5
    v_add_f32 v20, v5, v14
    s_waitcnt vmcnt(4)
L_STAT:
    v_xor_b32 v6, v38, v34
    v_xor_b32 v4, v39, v21
    v_lshrrev_b32 v5, 4, v4
    v_or_b32 v6, v5, v6
    v_cmp_ne_u32 vcc, 0, v6
    s_cbranch_vccz L_STATOK
    s_sub_u32 s60, s60, 1
    s_cbranch_scc1 L_STATOK
    s_cmp_gt_u32 s60, 0xffdf
    s_cbranch_scc1 L_NOALT
    v_xor_b32 v23, 0x10000, v23
L_NOALT:
    buffer_load_dwordx4 v[36:39], v23, s[20:23], s62 offen sc1
    s_waitcnt vmcnt(0)
    s_branch L_STAT
L_STATOK:
    v_cmp_eq_u32 vcc, s7, v4
    v_mov_b32 v5, 0x10000
    s_nop 0
    v_cndmask_b32 v4, 0, v5, vcc
    s_nop 1
    v_add_u32_dpp v8, v4, v22 row_newbcast:0 row_mask:0xf bank_mask:0xf
    v_add_u32_dpp v9, v4, v22 row_newbcast:1 row_mask:0xf bank_mask:0xf
    v_add_u32_dpp v10, v4, v22 row_newbcast:2 row_mask:0xf bank_mask:0xf
    v_add_u32_dpp v11, v4, v22 row_newbcast:3 row_mask:0xf bank_mask:0xf
    v_max_f32_dpp v56, v36, v36 quad_perm:[1,0,3,2] row_mask:0xf bank_mask:0xf
    s_nop 1
    v_max_f32_dpp v56, v56, v56 quad_perm:[2,3,0,1] row_mask:0xf bank_mask:0xf
    s_nop 1
    v_max_f32_dpp v56, v56, v56 row_half_mirror row_mask:0xf bank_mask:0xf
    v_max_f32 v56, v56, v20
    v_sub_f32 v57, v36, v56
    v_sub_f32 v58, v20, v56
    v_exp_f32 v57, v57
    v_exp_f32 v58, v58
    v_mul_f32 v59, v57, v37
    s_nop 1
    v_add_f32_dpp v59, v59, v59 quad_perm:[1,0,3,2] row_mask:0xf bank_mask:0xf
    s_nop 1
    v_add_f32_dpp v59, v59, v59 quad_perm:[2,3,0,1] row_mask:0xf bank_mask:0xf
    s_nop 1
    v_add_f32_dpp v59, v59, v59 row_half_mirror row_mask:0xf bank_mask:0xf
    v_add_f32 v59, v59, v58
    v_rcp_f32 v60, v59
    s_nop 0
    v_mul_f32 v57, v57, v60
    v_mul_f32 v58, v58, v60
    v_mul_f32 v5, v58, v15
    v_mul_f32 v6, v58, v16
    v_cndmask_b32 v64, v5, 0, s[56:57]
    v_cndmask_b32 v65, v6, 0, s[56:57]
    v_cndmask_b32 v66, 0, v5, s[56:57]
    v_cndmask_b32 v67, 0, v6, s[56:57]
    s_mov_b32 s60, 0x10000
    s_waitcnt vmcnt(0)
L_POLL:
    v_xor_b32 v40, s66, v40
    v_xor_b32 v41, s67, v41
    v_xor_b32 v42, s68, v42
    v_xor_b32 v43, s69, v43
    v_or3_b32 v61, v40, v41, v42
    v_xor_b32 v44, s66, v44
    v_xor_b32 v45, s67, v45
    v_xor_b32 v46, s68, v46
    v_xor_b32 v47, s69, v47
    v_or3_b32 v62, v43, v44, v45
    v_or3_b32 v61, v61, v46, v47
    v_xor_b32 v48, s66, v48
    v_xor_b32 v49, s67, v49
    v_xor_b32 v50, s68, v50
    v_xor_b32 v51, s69, v51
    v_or3_b32 v62, v62, v48, v49
    v_or3_b32 v61, v61, v50, v51
    v_xor_b32 v52, s66, v52
    v_xor_b32 v53, s67, v53
    v_xor_b32 v54, s68, v54
    v_xor_b32 v55, s69, v55
    v_or3_b32 v62, v62, v52, v53
    v_or3_b32 v61, v61, v54, v55
    v_or_b32 v61, v61, v62
    v_and_b32 v61, 0xff, v61
    v_cmp_ne_u32 vcc, 0, v61
    s_cbranch_vccz L_READY
    s_sub_u32 s60, s60, 1
    s_cbranch_scc1 L_READY
    s_cmp_lg_u32 s60, 0xfc00
    s_cbranch_scc1 L_NOSW
    v_mov_b32 v8, v22
    v_mov_b32 v9, v22
    v_mov_b32 v10, v22
    v_mov_b32 v11, v22
L_NOSW:
    buffer_load_dwordx4 v[40:43], v8, s[20:23], s62 offen offset:0 sc1
    buffer_load_dwordx4 v[44:47], v9, s[20:23], s62 offen offset:512 sc1
    buffer_load_dwordx4 v[48:51], v10, s[20:23], s62 offen offset:1024 sc1
    buffer_load_dwordx4 v[52:55], v11, s[20:23], s62 offen offset:1536 sc1
    s_waitcnt vmcnt(0)
    s_branch L_POLL
L_READY:
    v_fmac_f32_dpp v64, v57, v40 row_newbcast:0 row_mask:0xf bank_mask:0xf
    v_fmac_f32_dpp v65, v57, v41 row_newbcast:0 row_mask:0xf bank_mask:0xf
    v_fmac_f32_dpp v66, v57, v42 row_newbcast:0 row_mask:0xf bank_mask:0xf
    v_fmac_f32_dpp v67, v57, v43 row_newbcast:0 row_mask:0xf bank_mask:0xf
    v_fmac_f32_dpp v64, v57, v44 row_newbcast:1 row_mask:0xf bank_mask:0xf
    v_fmac_f32_dpp v65, v57, v45 row_newbcast:1 row_mask:0xf bank_mask:0xf
    v_fmac_f32_dpp v66, v57, v46 row_newbcast:1 row_mask:0xf bank_mask:0xf
    v_fmac_f32_dpp v67, v57, v47 row_newbcast:1 row_mask:0xf bank_mask:0xf
    v_fmac_f32_dpp v64, v57, v48 row_newbcast:2 row_mask:0xf bank_mask:0xf
    v_fmac_f32_dpp v65, v57, v49 row_newbcast:2 row_mask:0xf bank_mask:0xf
    v_fmac_f32_dpp v66, v57, v50 row_newbcast:2 row_mask:0xf bank_mask:0xf
    v_fmac_f32_dpp v67, v57, v51 row_newbcast:2 row_mask:0xf bank_mask:0xf
    v_fmac_f32_dpp v64, v57, v52 row_newbcast:3 row_mask:0xf bank_mask:0xf
    v_fmac_f32_dpp v65, v57, v53 row_newbcast:3 row_mask:0xf bank_mask:0xf
    v_fmac_f32_dpp v66, v57, v54 row_newbcast:3 row_mask:0xf bank_mask:0xf
    v_fmac_f32_dpp v67, v57, v55 row_newbcast:3 row_mask:0xf bank_mask:0xf
    s_nop 0
    v_permlane32_swap_b32 v64, v66
    v_permlane32_swap_b32 v65, v67
    v_add_f32 v64, v64, v66
    v_add_f32 v65, v65, v67
    v_cvt_pk_bf16_f32 v64, v64, v65
    s_lshl_b32 s4, s2, 8
    buffer_store_short v64, v17, s[24:27], s4 offen
    buffer_store_short_d16_hi v64, v17, s[24:27], s4 offen offset:16
    s_cmp_lg_u32 s59, 0
    s_cbranch_scc1 L_DONE
    v_mov_b32 v5, s63
    s_mov_b64 exec, 1
    buffer_store_dword v34, v5, s[20:23], 0 offen
    s_mov_b64 exec, -1
L_DONE:
L_END:
    s_endpgm
.section .rodata,"a"
.p2align 6
.amdhsa_kernel standalone__tree_speculative_verify_tree_attention_over_candidate_token_tree__decode_kernel
  .amdhsa_next_free_vgpr 232
  .amdhsa_next_free_sgpr 72
  .amdhsa_accum_offset 232
  .amdhsa_group_segment_fixed_size 0
  .amdhsa_kernarg_size 72
  .amdhsa_user_sgpr_count 2
  .amdhsa_user_sgpr_kernarg_segment_ptr 1
  .amdhsa_system_sgpr_workgroup_id_x 1
.end_amdhsa_kernel
```
